```python
import torch

def _softmax(x, axis=-1):
    return torch.softmax(x, dim=axis)
def _gelu(x):
    return torch.nn.functional.gelu(x, approximate="tanh")
def _silu(x):
    return torch.nn.functional.silu(x)
def _sigmoid(x):
    return torch.sigmoid(x)
def _layernorm(x, axis=-1, eps=1e-5):
    m = x.mean(dim=axis, keepdim=True)
    v = x.var(dim=axis, keepdim=True, unbiased=False)
    return (x - m) / torch.sqrt(v + eps)
def _scatter_add(tgt, idx, src, axis=0):
    return tgt.clone().index_add_(axis, idx, src)
def _segment_sum(src, seg, n):
    out = torch.zeros((n,) + src.shape[1:], dtype=src.dtype)
    return out.index_add_(0, seg, src)
def _pad(x, pw):
    flat = tuple(v for pair in reversed(pw) for v in pair)
    return torch.nn.functional.pad(x, flat)

kernel_name = 'standalone__gqa_softmax__sampling'

def setup_inputs():

    _w = (lambda a: (lambda t: t.to(torch.bfloat16) if t.is_floating_point() else t)(torch.as_tensor(a)))
    B, Hq, Hkv, Sq, Sk, D = 8, 32, 8, 32, 2048, 128
    return {
        "q": _w((lambda *s: torch.randn(*s, dtype=torch.bfloat16) * 0.8)(B, Hq, Sq, D)),
        "k": _w((lambda *s: torch.randn(*s, dtype=torch.bfloat16) * 0.8)(B, Hkv, Sk, D)),
        "v": _w((lambda *s: torch.randn(*s, dtype=torch.bfloat16) * 0.05)(B, Hkv, Sk, D)),
    }

def reference(q, k, v):
    B, Hq, Sq, D = q.shape
    Hkv = k.shape[1]
    rep = Hq // Hkv
    k = (lambda x, n, axis: torch.repeat_interleave(x, n, dim=axis))(k, rep, axis=1)
    v = (lambda x, n, axis: torch.repeat_interleave(x, n, dim=axis))(v, rep, axis=1)
    scale = D ** -0.5
    scores = torch.einsum("bhqd,bhkd->bhqk", q, k) * scale
    p = _softmax(scores, axis=-1)
    return torch.einsum("bhqk,bhkd->bhqd", p, v)
```

```asm
; @launch grid=(256,1,1) block=(512,1,1) lds=163840
.amdgcn_target "amdgcn-amd-amdhsa--gfx950"
.text
.globl standalone__gqa_softmax__sampling_kernel
.p2align 8
.type standalone__gqa_softmax__sampling_kernel,@function
standalone__gqa_softmax__sampling_kernel:
    s_cmp_ge_u32 s2, 256
    s_cbranch_scc1 L_end
    s_load_dwordx4 s[4:7], s[0:1], 0
    s_load_dwordx4 s[8:11], s[0:1], 16
    s_load_dwordx4 s[12:15], s[0:1], 32
    v_and_b32 v9, 63, v0
    v_lshrrev_b32 v10, 6, v0
    s_nop 0
    v_readfirstlane_b32 s36, v10
    s_and_b32 s37, s2, 7
    s_lshr_b32 s41, s2, 5
    s_lshl_b32 s41, s41, 3
    s_or_b32 s37, s37, s41
    s_bfe_u32 s50, s2, 0x10003
    s_bfe_u32 s38, s2, 0x10004
    s_and_b32 s51, s36, 1
    s_lshr_b32 s52, s36, 1
    s_lshl_b32 s39, s37, 19
    s_lshl_b32 s41, s38, 18
    s_add_u32 s39, s39, s41
    s_mov_b32 s40, 0x3e0293ee
    s_mov_b32 s65, 0
    v_lshrrev_b32 v10, 4, v9
    v_and_b32 v11, 15, v9
    s_lshl_b32 s44, s36, 2
    v_add_u32 v12, s44, v10
    v_and_b32 v4, 15, v12
    v_xor_b32 v13, v11, v4
    v_lshlrev_b32 v13, 4, v13
    v_lshl_add_u32 v7, v12, 8, v13
    v_lshlrev_b32 v13, 2, v10
    v_xor_b32 v13, v11, v13
    v_lshlrev_b32 v13, 4, v13
    v_lshl_add_u32 v8, v12, 8, v13
    s_lshl_b32 s45, s36, 10
    s_lshl_b32 s42, s37, 2
    s_lshl_b32 s41, s50, 1
    s_add_u32 s42, s42, s41
    s_lshl_b32 s57, s42, 13
    s_add_u32 s42, s42, s51
    s_lshl_b32 s43, s42, 13
    s_waitcnt lgkmcnt(0)
    s_mov_b32 s24, s4
    s_and_b32 s25, s5, 0xffff
    s_mov_b32 s26, 2097152
    s_mov_b32 s27, 0x00020000
    s_mov_b32 s16, s6
    s_and_b32 s17, s7, 0xffff
    s_mov_b32 s18, 33554432
    s_mov_b32 s19, 0x00020000
    s_mov_b32 s20, s8
    s_and_b32 s21, s9, 0xffff
    s_mov_b32 s22, 33554432
    s_mov_b32 s23, 0x00020000
    s_mov_b32 s28, s10
    s_and_b32 s29, s11, 0xffff
    s_mov_b32 s30, 2097152
    s_mov_b32 s31, 0x00020000
    s_mov_b32 s32, s14
    s_and_b32 s33, s15, 0xffff
    s_mov_b32 s34, 268435456
    s_mov_b32 s35, 0x00020000
    s_add_u32 m0, s45, 32768
    s_nop 0
    buffer_load_dwordx4 v7, s[24:27], s57 offen nt lds
    s_add_u32 s46, s57, 8192
    s_add_u32 m0, s45, 73728
    s_nop 0
    buffer_load_dwordx4 v7, s[24:27], s46 offen nt lds
    s_add_u32 s41, s65, 0
    s_and_b32 s41, s41, 7
    s_lshl_b32 s41, s41, 15
    s_add_u32 s41, s41, s39
    s_add_u32 s46, s41, 0
    s_add_u32 m0, s45, 0
    s_nop 0
    buffer_load_dwordx4 v7, s[16:19], s46 offen nt lds
    s_add_u32 s46, s41, 8192
    s_add_u32 m0, s45, 40960
    s_nop 0
    buffer_load_dwordx4 v7, s[16:19], s46 offen nt lds
    s_add_u32 s46, s41, 16384
    s_add_u32 m0, s45, 81920
    s_nop 0
    buffer_load_dwordx4 v7, s[16:19], s46 offen nt lds
    s_add_u32 s46, s41, 24576
    s_add_u32 m0, s45, 122880
    s_nop 0
    buffer_load_dwordx4 v7, s[16:19], s46 offen nt lds
    s_add_u32 s41, s65, 1
    s_and_b32 s41, s41, 7
    s_lshl_b32 s41, s41, 15
    s_add_u32 s41, s41, s39
    s_add_u32 s46, s41, 0
    s_add_u32 m0, s45, 8192
    s_nop 0
    buffer_load_dwordx4 v7, s[16:19], s46 offen nt lds
    s_add_u32 s46, s41, 8192
    s_add_u32 m0, s45, 49152
    s_nop 0
    buffer_load_dwordx4 v7, s[16:19], s46 offen nt lds
    s_add_u32 s46, s41, 16384
    s_add_u32 m0, s45, 90112
    s_nop 0
    buffer_load_dwordx4 v7, s[16:19], s46 offen nt lds
    s_add_u32 s46, s41, 24576
    s_add_u32 m0, s45, 131072
    s_nop 0
    buffer_load_dwordx4 v7, s[16:19], s46 offen nt lds
    s_add_u32 s41, s65, 0
    s_and_b32 s41, s41, 7
    s_lshl_b32 s41, s41, 15
    s_add_u32 s41, s41, s39
    s_add_u32 s46, s41, 0
    s_add_u32 m0, s45, 16384
    s_nop 0
    buffer_load_dwordx4 v8, s[20:23], s46 offen nt lds
    s_add_u32 s46, s41, 8192
    s_add_u32 m0, s45, 57344
    s_nop 0
    buffer_load_dwordx4 v8, s[20:23], s46 offen nt lds
    s_add_u32 s46, s41, 16384
    s_add_u32 m0, s45, 98304
    s_nop 0
    buffer_load_dwordx4 v8, s[20:23], s46 offen nt lds
    s_add_u32 s46, s41, 24576
    s_add_u32 m0, s45, 139264
    s_nop 0
    buffer_load_dwordx4 v8, s[20:23], s46 offen nt lds
    s_add_u32 s41, s65, 1
    s_and_b32 s41, s41, 7
    s_lshl_b32 s41, s41, 15
    s_add_u32 s41, s41, s39
    s_add_u32 s46, s41, 0
    s_add_u32 m0, s45, 24576
    s_nop 0
    buffer_load_dwordx4 v8, s[20:23], s46 offen nt lds
    s_add_u32 s46, s41, 8192
    s_add_u32 m0, s45, 65536
    s_nop 0
    buffer_load_dwordx4 v8, s[20:23], s46 offen nt lds
    s_add_u32 s46, s41, 16384
    s_add_u32 m0, s45, 106496
    s_nop 0
    buffer_load_dwordx4 v8, s[20:23], s46 offen nt lds
    s_add_u32 s46, s41, 24576
    s_add_u32 m0, s45, 147456
    s_nop 0
    buffer_load_dwordx4 v8, s[20:23], s46 offen nt lds
    s_cmp_lg_u32 s36, 0
    s_cbranch_scc1 L_noclr
    v_mov_b32 v48, 0
    v_mov_b32 v49, 0
    v_mov_b32 v50, 0
    v_mov_b32 v51, 0
    v_mov_b32 v10, 0
    s_lshl_b32 s47, s2, 7
    s_add_u32 s47, s47, 16777216
    v_cmp_eq_u32 vcc, 0, v9
    s_and_saveexec_b64 s[54:55], vcc
    buffer_store_dwordx4 v[48:51], v10, s[32:35], s47 offen sc0 sc1
    s_mov_b64 exec, s[54:55]
L_noclr:
    s_mul_i32 s47, s52, 40960
    v_and_b32 v10, 31, v9
    v_lshrrev_b32 v11, 5, v9
    v_and_b32 v12, 15, v9
    v_or_b32 v13, 0, v11
    v_xor_b32 v13, v13, v12
    v_lshlrev_b32 v13, 4, v13
    v_lshl_add_u32 v216, v10, 8, v13
    v_or_b32 v13, 2, v11
    v_xor_b32 v13, v13, v12
    v_lshlrev_b32 v13, 4, v13
    v_lshl_add_u32 v217, v10, 8, v13
    v_or_b32 v13, 4, v11
    v_xor_b32 v13, v13, v12
    v_lshlrev_b32 v13, 4, v13
    v_lshl_add_u32 v218, v10, 8, v13
    v_or_b32 v13, 6, v11
    v_xor_b32 v13, v13, v12
    v_lshlrev_b32 v13, 4, v13
    v_lshl_add_u32 v219, v10, 8, v13
    v_or_b32 v13, 8, v11
    v_xor_b32 v13, v13, v12
    v_lshlrev_b32 v13, 4, v13
    v_lshl_add_u32 v220, v10, 8, v13
    v_or_b32 v13, 10, v11
    v_xor_b32 v13, v13, v12
    v_lshlrev_b32 v13, 4, v13
    v_lshl_add_u32 v221, v10, 8, v13
    v_or_b32 v13, 12, v11
    v_xor_b32 v13, v13, v12
    v_lshlrev_b32 v13, 4, v13
    v_lshl_add_u32 v222, v10, 8, v13
    v_or_b32 v13, 14, v11
    v_xor_b32 v13, v13, v12
    v_lshlrev_b32 v13, 4, v13
    v_lshl_add_u32 v223, v10, 8, v13
    s_mul_i32 s48, s51, 40960
    s_add_u32 s48, s48, 32768
    v_add_u32 v64, s48, v216
    v_add_u32 v216, s47, v216
    v_add_u32 v65, s48, v217
    v_add_u32 v217, s47, v217
    v_add_u32 v66, s48, v218
    v_add_u32 v218, s47, v218
    v_add_u32 v67, s48, v219
    v_add_u32 v219, s47, v219
    v_add_u32 v68, s48, v220
    v_add_u32 v220, s47, v220
    v_add_u32 v69, s48, v221
    v_add_u32 v221, s47, v221
    v_add_u32 v70, s48, v222
    v_add_u32 v222, s47, v222
    v_add_u32 v71, s48, v223
    v_add_u32 v223, s47, v223
    v_lshrrev_b32 v10, 5, v9
    v_bfe_u32 v11, v9, 2, 2
    v_lshl_add_u32 v12, v10, 2, v11
    v_lshlrev_b32 v12, 8, v12
    v_bfe_u32 v10, v9, 4, 1
    v_lshl_add_u32 v12, v10, 5, v12
    v_and_b32 v10, 3, v9
    v_lshl_add_u32 v12, v10, 3, v12
    v_add_u32 v12, s47, v12
    v_add_u32 v12, 16384, v12
    v_xor_b32 v13, 0, v11
    v_lshl_add_u32 v224, v13, 6, v12
    v_xor_b32 v13, 1, v11
    v_lshl_add_u32 v225, v13, 6, v12
    v_xor_b32 v13, 2, v11
    v_lshl_add_u32 v226, v13, 6, v12
    v_xor_b32 v13, 3, v11
    v_lshl_add_u32 v227, v13, 6, v12
    v_mov_b32 v88, 0
    v_mov_b32 v89, 0
    v_mov_b32 v90, 0
    v_mov_b32 v91, 0
    v_mov_b32 v92, 0
    v_mov_b32 v93, 0
    v_mov_b32 v94, 0
    v_mov_b32 v95, 0
    v_mov_b32 v96, 0
    v_mov_b32 v97, 0
    v_mov_b32 v98, 0
    v_mov_b32 v99, 0
    v_mov_b32 v100, 0
    v_mov_b32 v101, 0
    v_mov_b32 v102, 0
    v_mov_b32 v103, 0
    v_mov_b32 v104, 0
    v_mov_b32 v105, 0
    v_mov_b32 v106, 0
    v_mov_b32 v107, 0
    v_mov_b32 v108, 0
    v_mov_b32 v109, 0
    v_mov_b32 v110, 0
    v_mov_b32 v111, 0
    v_mov_b32 v112, 0
    v_mov_b32 v113, 0
    v_mov_b32 v114, 0
    v_mov_b32 v115, 0
    v_mov_b32 v116, 0
    v_mov_b32 v117, 0
    v_mov_b32 v118, 0
    v_mov_b32 v119, 0
    v_mov_b32 v120, 0
    v_mov_b32 v121, 0
    v_mov_b32 v122, 0
    v_mov_b32 v123, 0
    v_mov_b32 v124, 0
    v_mov_b32 v125, 0
    v_mov_b32 v126, 0
    v_mov_b32 v127, 0
    v_mov_b32 v128, 0
    v_mov_b32 v129, 0
    v_mov_b32 v130, 0
    v_mov_b32 v131, 0
    v_mov_b32 v132, 0
    v_mov_b32 v133, 0
    v_mov_b32 v134, 0
    v_mov_b32 v135, 0
    v_mov_b32 v136, 0
    v_mov_b32 v137, 0
    v_mov_b32 v138, 0
    v_mov_b32 v139, 0
    v_mov_b32 v140, 0
    v_mov_b32 v141, 0
    v_mov_b32 v142, 0
    v_mov_b32 v143, 0
    v_mov_b32 v144, 0
    v_mov_b32 v145, 0
    v_mov_b32 v146, 0
    v_mov_b32 v147, 0
    v_mov_b32 v148, 0
    v_mov_b32 v149, 0
    v_mov_b32 v150, 0
    v_mov_b32 v151, 0
    v_mov_b32 v2, 0
    v_mov_b32 v1, 0xff800000
    v_mov_b32 v232, 0xff800000
    s_mov_b32 s60, 0
    s_mov_b32 s61, 0
    s_mov_b32 s62, 0
    s_mov_b32 s63, 16384
    s_add_u32 s68, s65, 2
    s_waitcnt vmcnt(12)
    s_cmp_lg_u32 s36, 0
    s_cbranch_scc1 L_nordy
    s_nop 0
L_nordy:
    s_barrier
    ds_read_b128 v[16:19], v64
    ds_read_b128 v[20:23], v65
    ds_read_b128 v[24:27], v66
    ds_read_b128 v[28:31], v67
    ds_read_b128 v[32:35], v68
    ds_read_b128 v[36:39], v69
    ds_read_b128 v[40:43], v70
    ds_read_b128 v[44:47], v71
    ds_read_b128 v[152:155], v216 offset:0
    ds_read_b128 v[156:159], v217 offset:0
    ds_read_b128 v[160:163], v218 offset:0
    ds_read_b128 v[164:167], v219 offset:0
    ds_read_b128 v[168:171], v220 offset:0
    ds_read_b128 v[172:175], v221 offset:0
    ds_read_b128 v[176:179], v222 offset:0
    ds_read_b128 v[180:183], v223 offset:0
    s_waitcnt lgkmcnt(0)
    v_mfma_f32_32x32x16_bf16 v[48:63], v[152:155], v[16:19], 0
    v_mfma_f32_32x32x16_bf16 v[48:63], v[156:159], v[20:23], v[48:63]
    v_mfma_f32_32x32x16_bf16 v[48:63], v[160:163], v[24:27], v[48:63]
    v_mfma_f32_32x32x16_bf16 v[48:63], v[164:167], v[28:31], v[48:63]
    v_mfma_f32_32x32x16_bf16 v[48:63], v[168:171], v[32:35], v[48:63]
    v_mfma_f32_32x32x16_bf16 v[48:63], v[172:175], v[36:39], v[48:63]
    v_mfma_f32_32x32x16_bf16 v[48:63], v[176:179], v[40:43], v[48:63]
    v_mfma_f32_32x32x16_bf16 v[48:63], v[180:183], v[44:47], v[48:63]
    s_nop 15
    v_max3_f32 v4, v48, v49, v50
    v_max3_f32 v4, v4, v51, v52
    v_max3_f32 v4, v4, v53, v54
    v_max3_f32 v4, v4, v55, v56
    v_max3_f32 v4, v4, v57, v58
    v_max3_f32 v4, v4, v59, v60
    v_max3_f32 v4, v4, v61, v62
    v_max_f32 v4, v4, v63
    v_mov_b32 v5, v4
    s_nop 1
    v_permlane32_swap_b32 v4, v5
    v_max_f32 v4, v4, v5
    s_nop 0
    v_cmp_gt_f32 vcc, v4, v232
    s_nop 1
    s_cbranch_vccnz L_rA0
L_bA0:
    v_fma_f32 v48, v48, s40, -v6
    v_fma_f32 v49, v49, s40, -v6
    v_fma_f32 v50, v50, s40, -v6
    v_fma_f32 v51, v51, s40, -v6
    v_fma_f32 v52, v52, s40, -v6
    v_fma_f32 v53, v53, s40, -v6
    v_fma_f32 v54, v54, s40, -v6
    v_fma_f32 v55, v55, s40, -v6
    v_fma_f32 v56, v56, s40, -v6
    v_fma_f32 v57, v57, s40, -v6
    v_fma_f32 v58, v58, s40, -v6
    v_fma_f32 v59, v59, s40, -v6
    v_fma_f32 v60, v60, s40, -v6
    v_fma_f32 v61, v61, s40, -v6
    v_fma_f32 v62, v62, s40, -v6
    v_fma_f32 v63, v63, s40, -v6
    v_exp_f32 v48, v48
    v_exp_f32 v49, v49
    v_exp_f32 v50, v50
    v_exp_f32 v51, v51
    v_exp_f32 v52, v52
    v_exp_f32 v53, v53
    v_exp_f32 v54, v54
    v_exp_f32 v55, v55
    v_exp_f32 v56, v56
    v_exp_f32 v57, v57
    v_exp_f32 v58, v58
    v_exp_f32 v59, v59
    v_exp_f32 v60, v60
    v_exp_f32 v61, v61
    v_exp_f32 v62, v62
    v_exp_f32 v63, v63
L_loop:
    s_waitcnt vmcnt(4)
    s_barrier
    s_cmp_ge_u32 s60, 3
    s_cbranch_scc1 L_noiss0
    s_and_b32 s58, s68, 7
    s_lshl_b32 s58, s58, 15
    s_add_u32 s58, s58, s39
    s_add_u32 s46, s58, 0
    s_add_u32 m0, s45, 0
    s_nop 0
    buffer_load_dwordx4 v7, s[16:19], s46 offen nt lds
    s_add_u32 s46, s58, 8192
    s_add_u32 m0, s45, 40960
    s_nop 0
    buffer_load_dwordx4 v7, s[16:19], s46 offen nt lds
    s_add_u32 s46, s58, 16384
    s_add_u32 m0, s45, 81920
    s_nop 0
    buffer_load_dwordx4 v7, s[16:19], s46 offen nt lds
    s_add_u32 s46, s58, 24576
    s_add_u32 m0, s45, 122880
    s_nop 0
    buffer_load_dwordx4 v7, s[16:19], s46 offen nt lds
    s_add_u32 s59, s45, s63
    s_add_u32 s46, s58, 0
    s_add_u32 m0, s59, 16384
    s_nop 0
    buffer_load_dwordx4 v8, s[20:23], s46 offen nt lds
    s_add_u32 s46, s58, 8192
    s_add_u32 m0, s59, 57344
    s_nop 0
    buffer_load_dwordx4 v8, s[20:23], s46 offen nt lds
    s_add_u32 s46, s58, 16384
    s_add_u32 m0, s59, 98304
    s_nop 0
    buffer_load_dwordx4 v8, s[20:23], s46 offen nt lds
    s_add_u32 s46, s58, 24576
    s_add_u32 m0, s59, 139264
    s_nop 0
    buffer_load_dwordx4 v8, s[20:23], s46 offen nt lds
L_noiss0:
    ds_read_b128 v[152:155], v216 offset:8192
    ds_read_b128 v[156:159], v217 offset:8192
    ds_read_b128 v[160:163], v218 offset:8192
    ds_read_b128 v[164:167], v219 offset:8192
    ds_read_b128 v[168:171], v220 offset:8192
    ds_read_b128 v[172:175], v221 offset:8192
    ds_read_b128 v[176:179], v222 offset:8192
    ds_read_b128 v[180:183], v223 offset:8192
    v_add_u32 v228, s61, v224
    v_add_u32 v229, s61, v225
    v_add_u32 v230, s61, v226
    v_add_u32 v231, s61, v227
    ds_read_b64_tr_b16 v[184:185], v228 offset:0
    ds_read_b64_tr_b16 v[186:187], v228 offset:2048
    ds_read_b64_tr_b16 v[192:193], v229 offset:0
    ds_read_b64_tr_b16 v[194:195], v229 offset:2048
    ds_read_b64_tr_b16 v[200:201], v230 offset:0
    ds_read_b64_tr_b16 v[202:203], v230 offset:2048
    ds_read_b64_tr_b16 v[208:209], v231 offset:0
    ds_read_b64_tr_b16 v[210:211], v231 offset:2048
    ds_read_b64_tr_b16 v[188:189], v228 offset:4096
    ds_read_b64_tr_b16 v[190:191], v228 offset:6144
    ds_read_b64_tr_b16 v[196:197], v229 offset:4096
    ds_read_b64_tr_b16 v[198:199], v229 offset:6144
    ds_read_b64_tr_b16 v[204:205], v230 offset:4096
    ds_read_b64_tr_b16 v[206:207], v230 offset:6144
    ds_read_b64_tr_b16 v[212:213], v231 offset:4096
    ds_read_b64_tr_b16 v[214:215], v231 offset:6144
    s_waitcnt lgkmcnt(15)
    v_mfma_f32_32x32x16_bf16 v[64:79], v[152:155], v[16:19], 0
    s_cmp_lg_u32 s62, 0
    s_cbranch_scc1 L_rB1
L_bB1:
    v_add_f32 v2, v2, v48
    v_add_f32 v2, v2, v49
    s_waitcnt lgkmcnt(15)
    v_mfma_f32_32x32x16_bf16 v[64:79], v[156:159], v[20:23], v[64:79]
    v_add_f32 v2, v2, v50
    v_add_f32 v2, v2, v51
    v_add_f32 v2, v2, v52
    s_waitcnt lgkmcnt(15)
    v_mfma_f32_32x32x16_bf16 v[64:79], v[160:163], v[24:27], v[64:79]
    v_add_f32 v2, v2, v53
    v_add_f32 v2, v2, v54
    v_add_f32 v2, v2, v55
    s_waitcnt lgkmcnt(15)
    v_mfma_f32_32x32x16_bf16 v[64:79], v[164:167], v[28:31], v[64:79]
    v_add_f32 v2, v2, v56
    v_add_f32 v2, v2, v57
    v_add_f32 v2, v2, v58
    s_waitcnt lgkmcnt(15)
    v_mfma_f32_32x32x16_bf16 v[64:79], v[168:171], v[32:35], v[64:79]
    v_add_f32 v2, v2, v59
    v_add_f32 v2, v2, v60
    v_add_f32 v2, v2, v61
    s_waitcnt lgkmcnt(15)
    v_mfma_f32_32x32x16_bf16 v[64:79], v[172:175], v[36:39], v[64:79]
    v_add_f32 v2, v2, v62
    v_add_f32 v2, v2, v63
    v_cvt_pk_bf16_f32 v80, v48, v49
    s_waitcnt lgkmcnt(15)
    v_mfma_f32_32x32x16_bf16 v[64:79], v[176:179], v[40:43], v[64:79]
    v_cvt_pk_bf16_f32 v81, v50, v51
    v_cvt_pk_bf16_f32 v82, v52, v53
    v_cvt_pk_bf16_f32 v83, v54, v55
    s_waitcnt lgkmcnt(15)
    v_mfma_f32_32x32x16_bf16 v[64:79], v[180:183], v[44:47], v[64:79]
    v_cvt_pk_bf16_f32 v84, v56, v57
    v_cvt_pk_bf16_f32 v85, v58, v59
    v_cvt_pk_bf16_f32 v86, v60, v61
    v_cvt_pk_bf16_f32 v87, v62, v63
    s_waitcnt lgkmcnt(0)
    s_nop 1
    v_mfma_f32_32x32x16_bf16 v[88:103], v[184:187], v[80:83], v[88:103]
    v_mfma_f32_32x32x16_bf16 v[104:119], v[192:195], v[80:83], v[104:119]
    s_nop 9
    v_mfma_f32_32x32x16_bf16 v[120:135], v[200:203], v[80:83], v[120:135]
    v_max3_f32 v4, v64, v65, v66
    v_max3_f32 v4, v4, v67, v68
    v_max3_f32 v4, v4, v69, v70
    v_max3_f32 v4, v4, v71, v72
    v_max3_f32 v4, v4, v73, v74
    v_max3_f32 v4, v4, v75, v76
    v_max3_f32 v4, v4, v77, v78
    v_max_f32 v4, v4, v79
    v_mov_b32 v5, v4
    s_nop 1
    v_mfma_f32_32x32x16_bf16 v[136:151], v[208:211], v[80:83], v[136:151]
    v_permlane32_swap_b32 v4, v5
    v_max_f32 v4, v4, v5
    s_nop 0
    v_cmp_gt_f32 vcc, v4, v232
    s_nop 1
    s_cbranch_vccnz L_rA2
L_bA2:
    v_fma_f32 v64, v64, s40, -v6
    v_fma_f32 v65, v65, s40, -v6
    v_fma_f32 v66, v66, s40, -v6
    v_fma_f32 v67, v67, s40, -v6
    v_fma_f32 v68, v68, s40, -v6
    v_fma_f32 v69, v69, s40, -v6
    v_fma_f32 v70, v70, s40, -v6
    v_mfma_f32_32x32x16_bf16 v[88:103], v[188:191], v[84:87], v[88:103]
    v_fma_f32 v71, v71, s40, -v6
    v_fma_f32 v72, v72, s40, -v6
    v_fma_f32 v73, v73, s40, -v6
    v_fma_f32 v74, v74, s40, -v6
    v_fma_f32 v75, v75, s40, -v6
    v_fma_f32 v76, v76, s40, -v6
    v_fma_f32 v77, v77, s40, -v6
    v_fma_f32 v78, v78, s40, -v6
    v_fma_f32 v79, v79, s40, -v6
    v_mfma_f32_32x32x16_bf16 v[104:119], v[196:199], v[84:87], v[104:119]
    v_exp_f32 v64, v64
    v_exp_f32 v65, v65
    v_exp_f32 v66, v66
    v_exp_f32 v67, v67
    v_exp_f32 v68, v68
    v_mfma_f32_32x32x16_bf16 v[120:135], v[204:207], v[84:87], v[120:135]
    v_exp_f32 v69, v69
    v_exp_f32 v70, v70
    v_exp_f32 v71, v71
    v_exp_f32 v72, v72
    v_exp_f32 v73, v73
    v_mfma_f32_32x32x16_bf16 v[136:151], v[212:215], v[84:87], v[136:151]
    v_exp_f32 v74, v74
    v_exp_f32 v75, v75
    v_exp_f32 v76, v76
    v_exp_f32 v77, v77
    v_exp_f32 v78, v78
    v_exp_f32 v79, v79
    s_add_u32 s68, s68, 1
    s_mov_b32 s63, s61
    s_add_u32 s61, s61, 8192
    s_cmp_eq_u32 s61, 24576
    s_cselect_b32 s61, 0, s61
    s_cmp_eq_u32 s60, 3
    s_cbranch_scc1 L_final
    s_waitcnt vmcnt(4)
    s_or_b32 s47, s36, s60
    s_cmp_lg_u32 s47, 0
    s_cbranch_scc1 L_nordy2
    s_and_b32 s48, s2, 3
    s_lshl_b32 s48, s48, 3
    s_lshl_b32 s49, 1, s48
    s_lshr_b32 s47, s2, 2
    s_lshl_b32 s47, s47, 2
    v_mov_b32 v10, s49
    v_mov_b32 v11, s47
    v_cmp_eq_u32 vcc, 0, v9
    s_and_saveexec_b64 s[54:55], vcc
    global_atomic_add v11, v10, s[12:13] sc1
    s_mov_b64 exec, s[54:55]
L_nordy2:
    s_barrier
    s_cmp_ge_u32 s60, 3
    s_cbranch_scc1 L_noiss1
    s_and_b32 s58, s68, 7
    s_lshl_b32 s58, s58, 15
    s_add_u32 s58, s58, s39
    s_add_u32 s46, s58, 0
    s_add_u32 m0, s45, 8192
    s_nop 0
    buffer_load_dwordx4 v7, s[16:19], s46 offen nt lds
    s_add_u32 s46, s58, 8192
    s_add_u32 m0, s45, 49152
    s_nop 0
    buffer_load_dwordx4 v7, s[16:19], s46 offen nt lds
    s_add_u32 s46, s58, 16384
    s_add_u32 m0, s45, 90112
    s_nop 0
    buffer_load_dwordx4 v7, s[16:19], s46 offen nt lds
    s_add_u32 s46, s58, 24576
    s_add_u32 m0, s45, 131072
    s_nop 0
    buffer_load_dwordx4 v7, s[16:19], s46 offen nt lds
    s_add_u32 s59, s45, s63
    s_add_u32 s46, s58, 0
    s_add_u32 m0, s59, 16384
    s_nop 0
    buffer_load_dwordx4 v8, s[20:23], s46 offen nt lds
    s_add_u32 s46, s58, 8192
    s_add_u32 m0, s59, 57344
    s_nop 0
    buffer_load_dwordx4 v8, s[20:23], s46 offen nt lds
    s_add_u32 s46, s58, 16384
    s_add_u32 m0, s59, 98304
    s_nop 0
    buffer_load_dwordx4 v8, s[20:23], s46 offen nt lds
    s_add_u32 s46, s58, 24576
    s_add_u32 m0, s59, 139264
    s_nop 0
    buffer_load_dwordx4 v8, s[20:23], s46 offen nt lds
L_noiss1:
    ds_read_b128 v[152:155], v216 offset:0
    ds_read_b128 v[156:159], v217 offset:0
    ds_read_b128 v[160:163], v218 offset:0
    ds_read_b128 v[164:167], v219 offset:0
    ds_read_b128 v[168:171], v220 offset:0
    ds_read_b128 v[172:175], v221 offset:0
    ds_read_b128 v[176:179], v222 offset:0
    ds_read_b128 v[180:183], v223 offset:0
    v_add_u32 v228, s61, v224
    v_add_u32 v229, s61, v225
    v_add_u32 v230, s61, v226
    v_add_u32 v231, s61, v227
    ds_read_b64_tr_b16 v[184:185], v228 offset:0
    ds_read_b64_tr_b16 v[186:187], v228 offset:2048
    ds_read_b64_tr_b16 v[192:193], v229 offset:0
    ds_read_b64_tr_b16 v[194:195], v229 offset:2048
    ds_read_b64_tr_b16 v[200:201], v230 offset:0
    ds_read_b64_tr_b16 v[202:203], v230 offset:2048
    ds_read_b64_tr_b16 v[208:209], v231 offset:0
    ds_read_b64_tr_b16 v[210:211], v231 offset:2048
    ds_read_b64_tr_b16 v[188:189], v228 offset:4096
    ds_read_b64_tr_b16 v[190:191], v228 offset:6144
    ds_read_b64_tr_b16 v[196:197], v229 offset:4096
    ds_read_b64_tr_b16 v[198:199], v229 offset:6144
    ds_read_b64_tr_b16 v[204:205], v230 offset:4096
    ds_read_b64_tr_b16 v[206:207], v230 offset:6144
    ds_read_b64_tr_b16 v[212:213], v231 offset:4096
    ds_read_b64_tr_b16 v[214:215], v231 offset:6144
    s_waitcnt lgkmcnt(15)
    v_mfma_f32_32x32x16_bf16 v[48:63], v[152:155], v[16:19], 0
    s_cmp_lg_u32 s62, 0
    s_cbranch_scc1 L_rB3
L_bB3:
    v_add_f32 v2, v2, v64
    v_add_f32 v2, v2, v65
    s_waitcnt lgkmcnt(15)
    v_mfma_f32_32x32x16_bf16 v[48:63], v[156:159], v[20:23], v[48:63]
    v_add_f32 v2, v2, v66
    v_add_f32 v2, v2, v67
    v_add_f32 v2, v2, v68
    s_waitcnt lgkmcnt(15)
    v_mfma_f32_32x32x16_bf16 v[48:63], v[160:163], v[24:27], v[48:63]
    v_add_f32 v2, v2, v69
    v_add_f32 v2, v2, v70
    v_add_f32 v2, v2, v71
    s_waitcnt lgkmcnt(15)
    v_mfma_f32_32x32x16_bf16 v[48:63], v[164:167], v[28:31], v[48:63]
    v_add_f32 v2, v2, v72
    v_add_f32 v2, v2, v73
    v_add_f32 v2, v2, v74
    s_waitcnt lgkmcnt(15)
    v_mfma_f32_32x32x16_bf16 v[48:63], v[168:171], v[32:35], v[48:63]
    v_add_f32 v2, v2, v75
    v_add_f32 v2, v2, v76
    v_add_f32 v2, v2, v77
    s_waitcnt lgkmcnt(15)
    v_mfma_f32_32x32x16_bf16 v[48:63], v[172:175], v[36:39], v[48:63]
    v_add_f32 v2, v2, v78
    v_add_f32 v2, v2, v79
    v_cvt_pk_bf16_f32 v80, v64, v65
    s_waitcnt lgkmcnt(15)
    v_mfma_f32_32x32x16_bf16 v[48:63], v[176:179], v[40:43], v[48:63]
    v_cvt_pk_bf16_f32 v81, v66, v67
    v_cvt_pk_bf16_f32 v82, v68, v69
    v_cvt_pk_bf16_f32 v83, v70, v71
    s_waitcnt lgkmcnt(15)
    v_mfma_f32_32x32x16_bf16 v[48:63], v[180:183], v[44:47], v[48:63]
    v_cvt_pk_bf16_f32 v84, v72, v73
    v_cvt_pk_bf16_f32 v85, v74, v75
    v_cvt_pk_bf16_f32 v86, v76, v77
    v_cvt_pk_bf16_f32 v87, v78, v79
    s_waitcnt lgkmcnt(0)
    s_nop 1
    v_mfma_f32_32x32x16_bf16 v[88:103], v[184:187], v[80:83], v[88:103]
    v_mfma_f32_32x32x16_bf16 v[104:119], v[192:195], v[80:83], v[104:119]
    s_nop 9
    v_mfma_f32_32x32x16_bf16 v[120:135], v[200:203], v[80:83], v[120:135]
    v_max3_f32 v4, v48, v49, v50
    v_max3_f32 v4, v4, v51, v52
    v_max3_f32 v4, v4, v53, v54
    v_max3_f32 v4, v4, v55, v56
    v_max3_f32 v4, v4, v57, v58
    v_max3_f32 v4, v4, v59, v60
    v_max3_f32 v4, v4, v61, v62
    v_max_f32 v4, v4, v63
    v_mov_b32 v5, v4
    s_nop 1
    v_mfma_f32_32x32x16_bf16 v[136:151], v[208:211], v[80:83], v[136:151]
    v_permlane32_swap_b32 v4, v5
    v_max_f32 v4, v4, v5
    s_nop 0
    v_cmp_gt_f32 vcc, v4, v232
    s_nop 1
    s_cbranch_vccnz L_rA4
L_bA4:
    v_fma_f32 v48, v48, s40, -v6
    v_fma_f32 v49, v49, s40, -v6
    v_fma_f32 v50, v50, s40, -v6
    v_fma_f32 v51, v51, s40, -v6
    v_fma_f32 v52, v52, s40, -v6
    v_fma_f32 v53, v53, s40, -v6
    v_fma_f32 v54, v54, s40, -v6
    v_mfma_f32_32x32x16_bf16 v[88:103], v[188:191], v[84:87], v[88:103]
    v_fma_f32 v55, v55, s40, -v6
    v_fma_f32 v56, v56, s40, -v6
    v_fma_f32 v57, v57, s40, -v6
    v_fma_f32 v58, v58, s40, -v6
    v_fma_f32 v59, v59, s40, -v6
    v_fma_f32 v60, v60, s40, -v6
    v_fma_f32 v61, v61, s40, -v6
    v_fma_f32 v62, v62, s40, -v6
    v_fma_f32 v63, v63, s40, -v6
    v_mfma_f32_32x32x16_bf16 v[104:119], v[196:199], v[84:87], v[104:119]
    v_exp_f32 v48, v48
    v_exp_f32 v49, v49
    v_exp_f32 v50, v50
    v_exp_f32 v51, v51
    v_exp_f32 v52, v52
    v_mfma_f32_32x32x16_bf16 v[120:135], v[204:207], v[84:87], v[120:135]
    v_exp_f32 v53, v53
    v_exp_f32 v54, v54
    v_exp_f32 v55, v55
    v_exp_f32 v56, v56
    v_exp_f32 v57, v57
    v_mfma_f32_32x32x16_bf16 v[136:151], v[212:215], v[84:87], v[136:151]
    v_exp_f32 v58, v58
    v_exp_f32 v59, v59
    v_exp_f32 v60, v60
    v_exp_f32 v61, v61
    v_exp_f32 v62, v62
    v_exp_f32 v63, v63
    s_add_u32 s68, s68, 1
    s_mov_b32 s63, s61
    s_add_u32 s61, s61, 8192
    s_cmp_eq_u32 s61, 24576
    s_cselect_b32 s61, 0, s61
    s_add_u32 s60, s60, 1
    s_branch L_loop
L_final:
    s_waitcnt vmcnt(0)
    s_barrier
    v_add_u32 v228, s61, v224
    v_add_u32 v229, s61, v225
    v_add_u32 v230, s61, v226
    v_add_u32 v231, s61, v227
    ds_read_b64_tr_b16 v[184:185], v228 offset:0
    ds_read_b64_tr_b16 v[186:187], v228 offset:2048
    ds_read_b64_tr_b16 v[192:193], v229 offset:0
    ds_read_b64_tr_b16 v[194:195], v229 offset:2048
    ds_read_b64_tr_b16 v[200:201], v230 offset:0
    ds_read_b64_tr_b16 v[202:203], v230 offset:2048
    ds_read_b64_tr_b16 v[208:209], v231 offset:0
    ds_read_b64_tr_b16 v[210:211], v231 offset:2048
    ds_read_b64_tr_b16 v[188:189], v228 offset:4096
    ds_read_b64_tr_b16 v[190:191], v228 offset:6144
    ds_read_b64_tr_b16 v[196:197], v229 offset:4096
    ds_read_b64_tr_b16 v[198:199], v229 offset:6144
    ds_read_b64_tr_b16 v[204:205], v230 offset:4096
    ds_read_b64_tr_b16 v[206:207], v230 offset:6144
    ds_read_b64_tr_b16 v[212:213], v231 offset:4096
    ds_read_b64_tr_b16 v[214:215], v231 offset:6144
    s_cmp_lg_u32 s62, 0
    s_cbranch_scc1 L_rB5
L_bB5:
    v_add_f32 v2, v2, v64
    v_add_f32 v2, v2, v65
    v_add_f32 v2, v2, v66
    v_add_f32 v2, v2, v67
    v_add_f32 v2, v2, v68
    v_add_f32 v2, v2, v69
    v_add_f32 v2, v2, v70
    v_add_f32 v2, v2, v71
    v_add_f32 v2, v2, v72
    v_add_f32 v2, v2, v73
    v_add_f32 v2, v2, v74
    v_add_f32 v2, v2, v75
    v_add_f32 v2, v2, v76
    v_add_f32 v2, v2, v77
    v_add_f32 v2, v2, v78
    v_add_f32 v2, v2, v79
    v_cvt_pk_bf16_f32 v80, v64, v65
    v_cvt_pk_bf16_f32 v81, v66, v67
    v_cvt_pk_bf16_f32 v82, v68, v69
    v_cvt_pk_bf16_f32 v83, v70, v71
    v_cvt_pk_bf16_f32 v84, v72, v73
    v_cvt_pk_bf16_f32 v85, v74, v75
    v_cvt_pk_bf16_f32 v86, v76, v77
    v_cvt_pk_bf16_f32 v87, v78, v79
    s_waitcnt lgkmcnt(0)
    s_nop 1
    v_mfma_f32_32x32x16_bf16 v[88:103], v[184:187], v[80:83], v[88:103]
    v_mfma_f32_32x32x16_bf16 v[104:119], v[192:195], v[80:83], v[104:119]
    v_mfma_f32_32x32x16_bf16 v[120:135], v[200:203], v[80:83], v[120:135]
    v_mfma_f32_32x32x16_bf16 v[136:151], v[208:211], v[80:83], v[136:151]
    v_mfma_f32_32x32x16_bf16 v[88:103], v[188:191], v[84:87], v[88:103]
    v_mfma_f32_32x32x16_bf16 v[104:119], v[196:199], v[84:87], v[104:119]
    v_mfma_f32_32x32x16_bf16 v[120:135], v[204:207], v[84:87], v[120:135]
    v_mfma_f32_32x32x16_bf16 v[136:151], v[212:215], v[84:87], v[136:151]
    s_xor_b32 s56, s2, 16
    s_lshr_b32 s47, s56, 2
    s_lshl_b32 s47, s47, 2
    v_mov_b32 v15, s47
    global_load_dword v14, v15, s[12:13] sc1
    v_mov_b32 v5, v2
    v_lshlrev_b32 v10, 4, v9
    s_nop 0
    v_permlane32_swap_b32 v2, v5
    v_add_f32 v2, v2, v5
    s_mul_i32 s47, s52, 40960
    s_mul_i32 s48, s51, 12288
    s_add_u32 s48, s48, s47
    v_add_u32 v11, s48, v10
    s_lshl_b32 s49, s51, 9
    s_add_u32 s49, s49, s47
    s_add_u32 s49, s49, 32768
    v_lshlrev_b32 v12, 3, v9
    v_add_u32 v13, s49, v12
    v_mov_b32 v4, v6
    v_mov_b32 v5, v2
    ds_write_b64 v13, v[4:5]
    s_cmp_lg_u32 s52, 0
    s_cbranch_scc1 L_mw1
    ds_write_b128 v11, v[104:107] offset:0
    ds_write_b128 v11, v[108:111] offset:1024
    ds_write_b128 v11, v[112:115] offset:2048
    ds_write_b128 v11, v[116:119] offset:3072
    ds_write_b128 v11, v[120:123] offset:4096
    ds_write_b128 v11, v[124:127] offset:5120
    ds_write_b128 v11, v[128:131] offset:6144
    ds_write_b128 v11, v[132:135] offset:7168
    ds_write_b128 v11, v[136:139] offset:8192
    ds_write_b128 v11, v[140:143] offset:9216
    ds_write_b128 v11, v[144:147] offset:10240
    ds_write_b128 v11, v[148:151] offset:11264
    v_mov_b32 v48, v88
    v_mov_b32 v49, v89
    v_mov_b32 v50, v90
    v_mov_b32 v51, v91
    v_mov_b32 v52, v92
    v_mov_b32 v53, v93
    v_mov_b32 v54, v94
    v_mov_b32 v55, v95
    v_mov_b32 v56, v96
    v_mov_b32 v57, v97
    v_mov_b32 v58, v98
    v_mov_b32 v59, v99
    v_mov_b32 v60, v100
    v_mov_b32 v61, v101
    v_mov_b32 v62, v102
    v_mov_b32 v63, v103
    s_branch L_mwdone
L_mw1:
    s_cmp_lg_u32 s52, 1
    s_cbranch_scc1 L_mw2
    ds_write_b128 v11, v[88:91] offset:0
    ds_write_b128 v11, v[92:95] offset:1024
    ds_write_b128 v11, v[96:99] offset:2048
    ds_write_b128 v11, v[100:103] offset:3072
    ds_write_b128 v11, v[120:123] offset:4096
    ds_write_b128 v11, v[124:127] offset:5120
    ds_write_b128 v11, v[128:131] offset:6144
    ds_write_b128 v11, v[132:135] offset:7168
    ds_write_b128 v11, v[136:139] offset:8192
    ds_write_b128 v11, v[140:143] offset:9216
    ds_write_b128 v11, v[144:147] offset:10240
    ds_write_b128 v11, v[148:151] offset:11264
    v_mov_b32 v48, v104
    v_mov_b32 v49, v105
    v_mov_b32 v50, v106
    v_mov_b32 v51, v107
    v_mov_b32 v52, v108
    v_mov_b32 v53, v109
    v_mov_b32 v54, v110
    v_mov_b32 v55, v111
    v_mov_b32 v56, v112
    v_mov_b32 v57, v113
    v_mov_b32 v58, v114
    v_mov_b32 v59, v115
    v_mov_b32 v60, v116
    v_mov_b32 v61, v117
    v_mov_b32 v62, v118
    v_mov_b32 v63, v119
    s_branch L_mwdone
L_mw2:
    s_cmp_lg_u32 s52, 2
    s_cbranch_scc1 L_mw3
    ds_write_b128 v11, v[88:91] offset:0
    ds_write_b128 v11, v[92:95] offset:1024
    ds_write_b128 v11, v[96:99] offset:2048
    ds_write_b128 v11, v[100:103] offset:3072
    ds_write_b128 v11, v[104:107] offset:4096
    ds_write_b128 v11, v[108:111] offset:5120
    ds_write_b128 v11, v[112:115] offset:6144
    ds_write_b128 v11, v[116:119] offset:7168
    ds_write_b128 v11, v[136:139] offset:8192
    ds_write_b128 v11, v[140:143] offset:9216
    ds_write_b128 v11, v[144:147] offset:10240
    ds_write_b128 v11, v[148:151] offset:11264
    v_mov_b32 v48, v120
    v_mov_b32 v49, v121
    v_mov_b32 v50, v122
    v_mov_b32 v51, v123
    v_mov_b32 v52, v124
    v_mov_b32 v53, v125
    v_mov_b32 v54, v126
    v_mov_b32 v55, v127
    v_mov_b32 v56, v128
    v_mov_b32 v57, v129
    v_mov_b32 v58, v130
    v_mov_b32 v59, v131
    v_mov_b32 v60, v132
    v_mov_b32 v61, v133
    v_mov_b32 v62, v134
    v_mov_b32 v63, v135
    s_branch L_mwdone
L_mw3:
    ds_write_b128 v11, v[88:91] offset:0
    ds_write_b128 v11, v[92:95] offset:1024
    ds_write_b128 v11, v[96:99] offset:2048
    ds_write_b128 v11, v[100:103] offset:3072
    ds_write_b128 v11, v[104:107] offset:4096
    ds_write_b128 v11, v[108:111] offset:5120
    ds_write_b128 v11, v[112:115] offset:6144
    ds_write_b128 v11, v[116:119] offset:7168
    ds_write_b128 v11, v[120:123] offset:8192
    ds_write_b128 v11, v[124:127] offset:9216
    ds_write_b128 v11, v[128:131] offset:10240
    ds_write_b128 v11, v[132:135] offset:11264
    v_mov_b32 v48, v136
    v_mov_b32 v49, v137
    v_mov_b32 v50, v138
    v_mov_b32 v51, v139
    v_mov_b32 v52, v140
    v_mov_b32 v53, v141
    v_mov_b32 v54, v142
    v_mov_b32 v55, v143
    v_mov_b32 v56, v144
    v_mov_b32 v57, v145
    v_mov_b32 v58, v146
    v_mov_b32 v59, v147
    v_mov_b32 v60, v148
    v_mov_b32 v61, v149
    v_mov_b32 v62, v150
    v_mov_b32 v63, v151
L_mwdone:
    s_waitcnt lgkmcnt(0)
    s_barrier
    s_add_u32 s47, s52, 1
    s_and_b32 s47, s47, 3
    s_mul_i32 s48, s47, 40960
    s_cmp_lt_u32 s52, s47
    s_cselect_b32 s49, 0, 1
    s_sub_u32 s49, s52, s49
    s_lshl_b32 s49, s49, 12
    s_add_u32 s49, s49, s48
    s_mul_i32 s46, s51, 12288
    s_add_u32 s49, s49, s46
    v_add_u32 v11, s49, v10
    ds_read_b128 v[152:155], v11 offset:0
    ds_read_b128 v[156:159], v11 offset:1024
    ds_read_b128 v[160:163], v11 offset:2048
    ds_read_b128 v[164:167], v11 offset:3072
    s_lshl_b32 s49, s51, 9
    s_add_u32 s49, s49, s48
    s_add_u32 s49, s49, 32768
    v_add_u32 v13, s49, v12
    ds_read_b64 v[18:19], v13
    s_add_u32 s47, s52, 2
    s_and_b32 s47, s47, 3
    s_mul_i32 s48, s47, 40960
    s_cmp_lt_u32 s52, s47
    s_cselect_b32 s49, 0, 1
    s_sub_u32 s49, s52, s49
    s_lshl_b32 s49, s49, 12
    s_add_u32 s49, s49, s48
    s_mul_i32 s46, s51, 12288
    s_add_u32 s49, s49, s46
    v_add_u32 v11, s49, v10
    ds_read_b128 v[168:171], v11 offset:0
    ds_read_b128 v[172:175], v11 offset:1024
    ds_read_b128 v[176:179], v11 offset:2048
    ds_read_b128 v[180:183], v11 offset:3072
    s_lshl_b32 s49, s51, 9
    s_add_u32 s49, s49, s48
    s_add_u32 s49, s49, 32768
    v_add_u32 v13, s49, v12
    ds_read_b64 v[20:21], v13
    s_add_u32 s47, s52, 3
    s_and_b32 s47, s47, 3
    s_mul_i32 s48, s47, 40960
    s_cmp_lt_u32 s52, s47
    s_cselect_b32 s49, 0, 1
    s_sub_u32 s49, s52, s49
    s_lshl_b32 s49, s49, 12
    s_add_u32 s49, s49, s48
    s_mul_i32 s46, s51, 12288
    s_add_u32 s49, s49, s46
    v_add_u32 v11, s49, v10
    ds_read_b128 v[184:187], v11 offset:0
    ds_read_b128 v[188:191], v11 offset:1024
    ds_read_b128 v[192:195], v11 offset:2048
    ds_read_b128 v[196:199], v11 offset:3072
    s_lshl_b32 s49, s51, 9
    s_add_u32 s49, s49, s48
    s_add_u32 s49, s49, 32768
    v_add_u32 v13, s49, v12
    ds_read_b64 v[22:23], v13
    v_mov_b32 v16, v6
    v_mov_b32 v17, v2
    s_waitcnt lgkmcnt(0)
    v_max3_f32 v4, v16, v18, v20
    v_max_f32 v6, v4, v22
    v_sub_f32 v24, v16, v6
    v_sub_f32 v25, v18, v6
    v_sub_f32 v26, v20, v6
    v_sub_f32 v27, v22, v6
    v_exp_f32 v24, v24
    v_exp_f32 v25, v25
    v_exp_f32 v26, v26
    v_exp_f32 v27, v27
    s_nop 0
    v_mul_f32 v2, v17, v24
    v_fmac_f32 v2, v19, v25
    v_fmac_f32 v2, v21, v26
    v_fmac_f32 v2, v23, v27
    v_mul_f32 v88, v48, v24
    v_fmac_f32 v88, v152, v25
    v_fmac_f32 v88, v168, v26
    v_fmac_f32 v88, v184, v27
    v_mul_f32 v89, v49, v24
    v_fmac_f32 v89, v153, v25
    v_fmac_f32 v89, v169, v26
    v_fmac_f32 v89, v185, v27
    v_mul_f32 v90, v50, v24
    v_fmac_f32 v90, v154, v25
    v_fmac_f32 v90, v170, v26
    v_fmac_f32 v90, v186, v27
    v_mul_f32 v91, v51, v24
    v_fmac_f32 v91, v155, v25
    v_fmac_f32 v91, v171, v26
    v_fmac_f32 v91, v187, v27
    v_mul_f32 v92, v52, v24
    v_fmac_f32 v92, v156, v25
    v_fmac_f32 v92, v172, v26
    v_fmac_f32 v92, v188, v27
    v_mul_f32 v93, v53, v24
    v_fmac_f32 v93, v157, v25
    v_fmac_f32 v93, v173, v26
    v_fmac_f32 v93, v189, v27
    v_mul_f32 v94, v54, v24
    v_fmac_f32 v94, v158, v25
    v_fmac_f32 v94, v174, v26
    v_fmac_f32 v94, v190, v27
    v_mul_f32 v95, v55, v24
    v_fmac_f32 v95, v159, v25
    v_fmac_f32 v95, v175, v26
    v_fmac_f32 v95, v191, v27
    v_mul_f32 v96, v56, v24
    v_fmac_f32 v96, v160, v25
    v_fmac_f32 v96, v176, v26
    v_fmac_f32 v96, v192, v27
    v_mul_f32 v97, v57, v24
    v_fmac_f32 v97, v161, v25
    v_fmac_f32 v97, v177, v26
    v_fmac_f32 v97, v193, v27
    v_mul_f32 v98, v58, v24
    v_fmac_f32 v98, v162, v25
    v_fmac_f32 v98, v178, v26
    v_fmac_f32 v98, v194, v27
    v_mul_f32 v99, v59, v24
    v_fmac_f32 v99, v163, v25
    v_fmac_f32 v99, v179, v26
    v_fmac_f32 v99, v195, v27
    v_mul_f32 v100, v60, v24
    v_fmac_f32 v100, v164, v25
    v_fmac_f32 v100, v180, v26
    v_fmac_f32 v100, v196, v27
    v_mul_f32 v101, v61, v24
    v_fmac_f32 v101, v165, v25
    v_fmac_f32 v101, v181, v26
    v_fmac_f32 v101, v197, v27
    v_mul_f32 v102, v62, v24
    v_fmac_f32 v102, v166, v25
    v_fmac_f32 v102, v182, v26
    v_fmac_f32 v102, v198, v27
    v_mul_f32 v103, v63, v24
    v_fmac_f32 v103, v167, v25
    v_fmac_f32 v103, v183, v26
    v_fmac_f32 v103, v199, v27
    s_cmp_eq_u32 s51, s38
    s_cbranch_scc1 L_consumer
    s_and_b32 s48, s56, 3
    s_lshl_b32 s48, s48, 3
    s_add_u32 s48, s48, 0x80000
    s_waitcnt vmcnt(0)
L_rdy:
    v_readfirstlane_b32 s46, v14
    s_bfe_u32 s46, s46, s48
    s_cmp_ge_u32 s46, 1
    s_cbranch_scc1 L_rdy_ok
    s_sleep 4
    global_load_dword v14, v15, s[12:13] sc1
    s_waitcnt vmcnt(0)
    s_branch L_rdy
L_rdy_ok:
    s_lshl_b32 s48, s56, 2
    s_add_u32 s48, s48, s52
    s_lshl_b32 s48, s48, 13
    buffer_store_dwordx4 v[88:91], v10, s[32:35], s48 offen offset:0 sc0 sc1
    buffer_store_dwordx4 v[92:95], v10, s[32:35], s48 offen offset:1024 sc0 sc1
    buffer_store_dwordx4 v[96:99], v10, s[32:35], s48 offen offset:2048 sc0 sc1
    buffer_store_dwordx4 v[100:103], v10, s[32:35], s48 offen offset:3072 sc0 sc1
    s_add_u32 s48, s48, 4096
    v_mov_b32 v4, v6
    v_mov_b32 v5, v2
    buffer_store_dwordx2 v[4:5], v12, s[32:35], s48 offen sc0 sc1
    s_waitcnt vmcnt(0)
    s_lshl_b32 s48, s56, 7
    s_lshl_b32 s47, s52, 2
    s_add_u32 s48, s48, s47
    s_add_u32 s48, s48, 16777216
    v_mov_b32 v4, 1
    v_mov_b32 v5, 0
    v_cmp_eq_u32 vcc, 0, v9
    s_and_saveexec_b64 s[54:55], vcc
    buffer_store_dword v4, v5, s[32:35], s48 offen sc0 sc1
    s_branch L_end
L_consumer:
    s_lshl_b32 s48, s2, 7
    s_lshl_b32 s47, s52, 2
    s_add_u32 s48, s48, s47
    s_add_u32 s48, s48, 16777216
    v_mov_b32 v5, 0
L_poll:
    buffer_load_dword v13, v5, s[32:35], s48 offen sc0 sc1
    s_waitcnt vmcnt(0)
    v_readfirstlane_b32 s46, v13
    s_cmp_eq_u32 s46, 1
    s_cbranch_scc1 L_go
    s_branch L_poll
L_go:
    s_lshl_b32 s48, s2, 2
    s_add_u32 s48, s48, s52
    s_lshl_b32 s48, s48, 13
    buffer_load_dwordx4 v[152:155], v10, s[32:35], s48 offen offset:0 sc0 sc1
    buffer_load_dwordx4 v[156:159], v10, s[32:35], s48 offen offset:1024 sc0 sc1
    buffer_load_dwordx4 v[160:163], v10, s[32:35], s48 offen offset:2048 sc0 sc1
    buffer_load_dwordx4 v[164:167], v10, s[32:35], s48 offen offset:3072 sc0 sc1
    s_add_u32 s48, s48, 4096
    buffer_load_dwordx2 v[16:17], v12, s[32:35], s48 offen sc0 sc1
    s_waitcnt vmcnt(0)
    v_max_f32 v4, v6, v16
    v_sub_f32 v18, v6, v4
    v_sub_f32 v19, v16, v4
    v_exp_f32 v18, v18
    v_exp_f32 v19, v19
    s_nop 0
    v_mul_f32 v2, v2, v18
    v_fmac_f32 v2, v17, v19
    v_rcp_f32 v2, v2
    s_nop 0
    v_mul_f32 v18, v18, v2
    v_mul_f32 v19, v19, v2
    v_mul_f32 v88, v88, v18
    v_fmac_f32 v88, v152, v19
    v_mul_f32 v89, v89, v18
    v_fmac_f32 v89, v153, v19
    v_mul_f32 v90, v90, v18
    v_fmac_f32 v90, v154, v19
    v_mul_f32 v91, v91, v18
    v_fmac_f32 v91, v155, v19
    v_mul_f32 v92, v92, v18
    v_fmac_f32 v92, v156, v19
    v_mul_f32 v93, v93, v18
    v_fmac_f32 v93, v157, v19
    v_mul_f32 v94, v94, v18
    v_fmac_f32 v94, v158, v19
    v_mul_f32 v95, v95, v18
    v_fmac_f32 v95, v159, v19
    v_mul_f32 v96, v96, v18
    v_fmac_f32 v96, v160, v19
    v_mul_f32 v97, v97, v18
    v_fmac_f32 v97, v161, v19
    v_mul_f32 v98, v98, v18
    v_fmac_f32 v98, v162, v19
    v_mul_f32 v99, v99, v18
    v_fmac_f32 v99, v163, v19
    v_mul_f32 v100, v100, v18
    v_fmac_f32 v100, v164, v19
    v_mul_f32 v101, v101, v18
    v_fmac_f32 v101, v165, v19
    v_mul_f32 v102, v102, v18
    v_fmac_f32 v102, v166, v19
    v_mul_f32 v103, v103, v18
    v_fmac_f32 v103, v167, v19
    v_and_b32 v10, 31, v9
    v_lshrrev_b32 v11, 5, v9
    v_lshlrev_b32 v10, 8, v10
    v_lshl_add_u32 v10, v11, 3, v10
    s_lshl_b32 s47, s52, 6
    s_add_u32 s47, s47, s43
    v_cvt_pk_bf16_f32 v24, v88, v89
    v_cvt_pk_bf16_f32 v25, v90, v91
    v_cvt_pk_bf16_f32 v26, v92, v93
    v_cvt_pk_bf16_f32 v27, v94, v95
    v_cvt_pk_bf16_f32 v28, v96, v97
    v_cvt_pk_bf16_f32 v29, v98, v99
    v_cvt_pk_bf16_f32 v30, v100, v101
    v_cvt_pk_bf16_f32 v31, v102, v103
    buffer_store_dwordx2 v[24:25], v10, s[28:31], s47 offen offset:0
    buffer_store_dwordx2 v[26:27], v10, s[28:31], s47 offen offset:16
    buffer_store_dwordx2 v[28:29], v10, s[28:31], s47 offen offset:32
    buffer_store_dwordx2 v[30:31], v10, s[28:31], s47 offen offset:48
L_end:
    s_endpgm
L_rA0:
    v_max_f32 v4, v4, v1
    v_sub_f32 v3, v1, v4
    v_mul_f32 v3, s40, v3
    v_exp_f32 v3, v3
    v_mov_b32 v1, v4
    v_mul_f32 v6, s40, v4
    v_add_f32 v232, 0x42700000, v4
    s_mov_b32 s62, 1
    s_branch L_bA0
L_rB1:
    v_mul_f32 v2, v2, v3
    v_mul_f32 v88, v88, v3
    v_mul_f32 v89, v89, v3
    v_mul_f32 v90, v90, v3
    v_mul_f32 v91, v91, v3
    v_mul_f32 v92, v92, v3
    v_mul_f32 v93, v93, v3
    v_mul_f32 v94, v94, v3
    v_mul_f32 v95, v95, v3
    v_mul_f32 v96, v96, v3
    v_mul_f32 v97, v97, v3
    v_mul_f32 v98, v98, v3
    v_mul_f32 v99, v99, v3
    v_mul_f32 v100, v100, v3
    v_mul_f32 v101, v101, v3
    v_mul_f32 v102, v102, v3
    v_mul_f32 v103, v103, v3
    v_mul_f32 v104, v104, v3
    v_mul_f32 v105, v105, v3
    v_mul_f32 v106, v106, v3
    v_mul_f32 v107, v107, v3
    v_mul_f32 v108, v108, v3
    v_mul_f32 v109, v109, v3
    v_mul_f32 v110, v110, v3
    v_mul_f32 v111, v111, v3
    v_mul_f32 v112, v112, v3
    v_mul_f32 v113, v113, v3
    v_mul_f32 v114, v114, v3
    v_mul_f32 v115, v115, v3
    v_mul_f32 v116, v116, v3
    v_mul_f32 v117, v117, v3
    v_mul_f32 v118, v118, v3
    v_mul_f32 v119, v119, v3
    v_mul_f32 v120, v120, v3
    v_mul_f32 v121, v121, v3
    v_mul_f32 v122, v122, v3
    v_mul_f32 v123, v123, v3
    v_mul_f32 v124, v124, v3
    v_mul_f32 v125, v125, v3
    v_mul_f32 v126, v126, v3
    v_mul_f32 v127, v127, v3
    v_mul_f32 v128, v128, v3
    v_mul_f32 v129, v129, v3
    v_mul_f32 v130, v130, v3
    v_mul_f32 v131, v131, v3
    v_mul_f32 v132, v132, v3
    v_mul_f32 v133, v133, v3
    v_mul_f32 v134, v134, v3
    v_mul_f32 v135, v135, v3
    v_mul_f32 v136, v136, v3
    v_mul_f32 v137, v137, v3
    v_mul_f32 v138, v138, v3
    v_mul_f32 v139, v139, v3
    v_mul_f32 v140, v140, v3
    v_mul_f32 v141, v141, v3
    v_mul_f32 v142, v142, v3
    v_mul_f32 v143, v143, v3
    v_mul_f32 v144, v144, v3
    v_mul_f32 v145, v145, v3
    v_mul_f32 v146, v146, v3
    v_mul_f32 v147, v147, v3
    v_mul_f32 v148, v148, v3
    v_mul_f32 v149, v149, v3
    v_mul_f32 v150, v150, v3
    v_mul_f32 v151, v151, v3
    s_mov_b32 s62, 0
    s_branch L_bB1
L_rA2:
    v_max_f32 v4, v4, v1
    v_sub_f32 v3, v1, v4
    v_mul_f32 v3, s40, v3
    v_exp_f32 v3, v3
    v_mov_b32 v1, v4
    v_mul_f32 v6, s40, v4
    v_add_f32 v232, 0x42700000, v4
    s_mov_b32 s62, 1
    s_branch L_bA2
L_rB3:
    v_mul_f32 v2, v2, v3
    v_mul_f32 v88, v88, v3
    v_mul_f32 v89, v89, v3
    v_mul_f32 v90, v90, v3
    v_mul_f32 v91, v91, v3
    v_mul_f32 v92, v92, v3
    v_mul_f32 v93, v93, v3
    v_mul_f32 v94, v94, v3
    v_mul_f32 v95, v95, v3
    v_mul_f32 v96, v96, v3
    v_mul_f32 v97, v97, v3
    v_mul_f32 v98, v98, v3
    v_mul_f32 v99, v99, v3
    v_mul_f32 v100, v100, v3
    v_mul_f32 v101, v101, v3
    v_mul_f32 v102, v102, v3
    v_mul_f32 v103, v103, v3
    v_mul_f32 v104, v104, v3
    v_mul_f32 v105, v105, v3
    v_mul_f32 v106, v106, v3
    v_mul_f32 v107, v107, v3
    v_mul_f32 v108, v108, v3
    v_mul_f32 v109, v109, v3
    v_mul_f32 v110, v110, v3
    v_mul_f32 v111, v111, v3
    v_mul_f32 v112, v112, v3
    v_mul_f32 v113, v113, v3
    v_mul_f32 v114, v114, v3
    v_mul_f32 v115, v115, v3
    v_mul_f32 v116, v116, v3
    v_mul_f32 v117, v117, v3
    v_mul_f32 v118, v118, v3
    v_mul_f32 v119, v119, v3
    v_mul_f32 v120, v120, v3
    v_mul_f32 v121, v121, v3
    v_mul_f32 v122, v122, v3
    v_mul_f32 v123, v123, v3
    v_mul_f32 v124, v124, v3
    v_mul_f32 v125, v125, v3
    v_mul_f32 v126, v126, v3
    v_mul_f32 v127, v127, v3
    v_mul_f32 v128, v128, v3
    v_mul_f32 v129, v129, v3
    v_mul_f32 v130, v130, v3
    v_mul_f32 v131, v131, v3
    v_mul_f32 v132, v132, v3
    v_mul_f32 v133, v133, v3
    v_mul_f32 v134, v134, v3
    v_mul_f32 v135, v135, v3
    v_mul_f32 v136, v136, v3
    v_mul_f32 v137, v137, v3
    v_mul_f32 v138, v138, v3
    v_mul_f32 v139, v139, v3
    v_mul_f32 v140, v140, v3
    v_mul_f32 v141, v141, v3
    v_mul_f32 v142, v142, v3
    v_mul_f32 v143, v143, v3
    v_mul_f32 v144, v144, v3
    v_mul_f32 v145, v145, v3
    v_mul_f32 v146, v146, v3
    v_mul_f32 v147, v147, v3
    v_mul_f32 v148, v148, v3
    v_mul_f32 v149, v149, v3
    v_mul_f32 v150, v150, v3
    v_mul_f32 v151, v151, v3
    s_mov_b32 s62, 0
    s_branch L_bB3
L_rA4:
    v_max_f32 v4, v4, v1
    v_sub_f32 v3, v1, v4
    v_mul_f32 v3, s40, v3
    v_exp_f32 v3, v3
    v_mov_b32 v1, v4
    v_mul_f32 v6, s40, v4
    v_add_f32 v232, 0x42700000, v4
    s_mov_b32 s62, 1
    s_branch L_bA4
L_rB5:
    v_mul_f32 v2, v2, v3
    v_mul_f32 v88, v88, v3
    v_mul_f32 v89, v89, v3
    v_mul_f32 v90, v90, v3
    v_mul_f32 v91, v91, v3
    v_mul_f32 v92, v92, v3
    v_mul_f32 v93, v93, v3
    v_mul_f32 v94, v94, v3
    v_mul_f32 v95, v95, v3
    v_mul_f32 v96, v96, v3
    v_mul_f32 v97, v97, v3
    v_mul_f32 v98, v98, v3
    v_mul_f32 v99, v99, v3
    v_mul_f32 v100, v100, v3
    v_mul_f32 v101, v101, v3
    v_mul_f32 v102, v102, v3
    v_mul_f32 v103, v103, v3
    v_mul_f32 v104, v104, v3
    v_mul_f32 v105, v105, v3
    v_mul_f32 v106, v106, v3
    v_mul_f32 v107, v107, v3
    v_mul_f32 v108, v108, v3
    v_mul_f32 v109, v109, v3
    v_mul_f32 v110, v110, v3
    v_mul_f32 v111, v111, v3
    v_mul_f32 v112, v112, v3
    v_mul_f32 v113, v113, v3
    v_mul_f32 v114, v114, v3
    v_mul_f32 v115, v115, v3
    v_mul_f32 v116, v116, v3
    v_mul_f32 v117, v117, v3
    v_mul_f32 v118, v118, v3
    v_mul_f32 v119, v119, v3
    v_mul_f32 v120, v120, v3
    v_mul_f32 v121, v121, v3
    v_mul_f32 v122, v122, v3
    v_mul_f32 v123, v123, v3
    v_mul_f32 v124, v124, v3
    v_mul_f32 v125, v125, v3
    v_mul_f32 v126, v126, v3
    v_mul_f32 v127, v127, v3
    v_mul_f32 v128, v128, v3
    v_mul_f32 v129, v129, v3
    v_mul_f32 v130, v130, v3
    v_mul_f32 v131, v131, v3
    v_mul_f32 v132, v132, v3
    v_mul_f32 v133, v133, v3
    v_mul_f32 v134, v134, v3
    v_mul_f32 v135, v135, v3
    v_mul_f32 v136, v136, v3
    v_mul_f32 v137, v137, v3
    v_mul_f32 v138, v138, v3
    v_mul_f32 v139, v139, v3
    v_mul_f32 v140, v140, v3
    v_mul_f32 v141, v141, v3
    v_mul_f32 v142, v142, v3
    v_mul_f32 v143, v143, v3
    v_mul_f32 v144, v144, v3
    v_mul_f32 v145, v145, v3
    v_mul_f32 v146, v146, v3
    v_mul_f32 v147, v147, v3
    v_mul_f32 v148, v148, v3
    v_mul_f32 v149, v149, v3
    v_mul_f32 v150, v150, v3
    v_mul_f32 v151, v151, v3
    s_mov_b32 s62, 0
    s_branch L_bB5

.section .rodata,"a"
.p2align 6
.amdhsa_kernel standalone__gqa_softmax__sampling_kernel
  .amdhsa_next_free_vgpr 236
  .amdhsa_next_free_sgpr 102
  .amdhsa_accum_offset 236
  .amdhsa_group_segment_fixed_size 0
  .amdhsa_kernarg_size 48
  .amdhsa_user_sgpr_count 2
  .amdhsa_user_sgpr_kernarg_segment_ptr 1
  .amdhsa_system_sgpr_workgroup_id_x 1
.end_amdhsa_kernel
```
